```python
import torch

def _softmax(x, axis=-1):
    return torch.softmax(x, dim=axis)
def _gelu(x):
    return torch.nn.functional.gelu(x, approximate="tanh")
def _silu(x):
    return torch.nn.functional.silu(x)
def _sigmoid(x):
    return torch.sigmoid(x)
def _layernorm(x, axis=-1, eps=1e-5):
    m = x.mean(dim=axis, keepdim=True)
    v = x.var(dim=axis, keepdim=True, unbiased=False)
    return (x - m) / torch.sqrt(v + eps)
def _scatter_add(tgt, idx, src, axis=0):
    return tgt.clone().index_add_(axis, idx, src)
def _segment_sum(src, seg, n):
    out = torch.zeros((n,) + src.shape[1:], dtype=src.dtype)
    return out.index_add_(0, seg, src)
def _pad(x, pw):
    flat = tuple(v for pair in reversed(pw) for v in pair)
    return torch.nn.functional.pad(x, flat)

kernel_name = 'standalone__mha_block_cached__decode'

def setup_inputs():

    _w = (lambda a: (lambda t: t.to(torch.bfloat16) if t.is_floating_point() else t)(torch.as_tensor(a)))
    B, Sq, D = 2, 1, 448
    H, Sk, Dh = 16, 8192, 256
    return {
        "x": _w((lambda *s: torch.randn(*s, dtype=torch.bfloat16) * 0.8)(B, Sq, D)),
        "k_cache": _w((lambda *s: torch.randn(*s, dtype=torch.bfloat16) * 0.8)(B, H, Sk, Dh)),
        "v_cache": _w((lambda *s: torch.randn(*s, dtype=torch.bfloat16) * 0.05)(B, H, Sk, Dh)),
        "wq": _w((lambda *s: torch.randn(*s, dtype=torch.bfloat16) * 0.8)(D, H * Dh) * (D ** -0.5)),
        "wo": _w((lambda *s: torch.randn(*s, dtype=torch.bfloat16) * 0.05)(H * Dh, D) * ((H * Dh) ** -0.5)),
    }

def reference(x, k_cache, v_cache, wq, wo):
    B, Sq, D = x.shape
    H, Dh = 16, 256
    q = (lambda x, *d: x.permute(*d))((x @ wq).reshape(B, Sq, H, Dh), 0, 2, 1, 3)
    scores = torch.einsum("bhqd,bhkd->bhqk", q, k_cache) * (Dh ** -0.5)
    p = _softmax(scores, axis=-1)
    o = torch.einsum("bhqk,bhkd->bhqd", p, v_cache)
    return (lambda x, *d: x.permute(*d))(o, 0, 2, 1, 3).reshape(B, Sq, H * Dh) @ wo
```

```asm
; @launch grid=(256,1,1) block=(512,1,1) lds=40960
.amdgcn_target "amdgcn-amd-amdhsa--gfx950"
.text
.globl standalone__mha_block_cached__decode_kernel
.p2align 8
.type standalone__mha_block_cached__decode_kernel,@function
standalone__mha_block_cached__decode_kernel:
    s_cmp_ge_u32 s2, 256
    s_cbranch_scc1 L_end
    s_load_dwordx16 s[4:19], s[0:1], 0
    s_memrealtime s[42:43]
    v_lshrrev_b32 v1, 6, v0
    v_and_b32 v2, 63, v0
    v_readfirstlane_b32 s20, v1
    v_lshrrev_b32 v3, 4, v2
    v_and_b32 v4, 15, v2
    s_and_b32 s23, s2, 7
    s_bfe_u32 s27, s2, 0x10003
    s_lshl1_add_u32 s37, s23, s27
    s_and_b32 s27, s2, 16
    s_or_b32 s21, s37, s27
    s_lshr_b32 s22, s2, 5
    s_cmp_ge_u32 s20, 4
    s_cbranch_scc1 L_helper
    s_lshr_b32 s38, s21, 4
    s_lshr_b32 s28, s22, 2
    s_lshl1_add_u32 s28, s38, s28
    s_mul_i32 s28, s28, 112
    s_lshl3_add_u32 s28, s20, s28
    v_lshrrev_b32 v8, 3, v2
    v_and_b32 v9, 7, v2
    v_add_u32 v10, s28, v8
    v_lshlrev_b32 v10, 13, v10
    v_lshl_add_u32 v10, v9, 4, v10
    s_and_b32 s28, s22, 3
    s_lshl2_add_u32 s28, s37, s28
    s_lshl_b32 s28, s28, 7
    v_add_u32 v10, s28, v10
    s_lshl_b32 s24, s20, 10
    s_add_u32 m0, s24, 10240
    s_lshl_b32 s34, s20, 12
    s_waitcnt lgkmcnt(0)
    global_load_lds_dwordx4 v10, s[10:11] nt
    s_add_u32 m0, s24, 14336
    v_add_u32 v10, 0x40000, v10
    global_load_lds_dwordx4 v10, s[10:11] nt
    s_add_u32 m0, s24, 18432
    v_add_u32 v10, 0x40000, v10
    global_load_lds_dwordx4 v10, s[10:11] nt
    s_cmp_ge_u32 s20, 2
    s_cbranch_scc1 L_nq3
    s_add_u32 m0, s24, 22528
    v_add_u32 v10, 0x40000, v10
    global_load_lds_dwordx4 v10, s[10:11] nt
L_nq3:
    s_bfe_u32 s28, s2, 0x20003
    s_lshl2_add_u32 s28, s23, s28
    s_lshl2_add_u32 s28, s28, s20
    s_lshl_b32 s28, s28, 5
    v_add_u32 v8, s28, v8
    v_mul_u32_u24 v8, 896, v8
    s_min_u32 s28, s22, 6
    s_lshl_b32 s28, s28, 7
    v_add_u32 v8, s28, v8
    v_and_b32 v11, 1, v3
    v_lshlrev_b32 v11, 1, v11
    v_xor_b32 v11, v11, v9
    v_lshl_add_u32 v11, v11, 4, v8
    s_cmp_eq_u32 s22, 7
    s_cselect_b64 s[40:41], 0xff, -1
    s_add_u32 m0, s34, 24576
    s_nop 0
    s_mov_b64 exec, s[40:41]
    global_load_lds_dwordx4 v11, s[12:13] nt
    s_mov_b64 exec, -1
    s_add_u32 m0, s34, 25600
    v_xor_b32 v11, 64, v11
    v_add_u32 v11, 7168, v11
    s_mov_b64 exec, s[40:41]
    global_load_lds_dwordx4 v11, s[12:13] nt
    s_mov_b64 exec, -1
    s_add_u32 m0, s34, 26624
    v_xor_b32 v11, 64, v11
    v_add_u32 v11, 7168, v11
    s_mov_b64 exec, s[40:41]
    global_load_lds_dwordx4 v11, s[12:13] nt
    s_mov_b64 exec, -1
    v_lshlrev_b32 v5, 9, v3
    v_lshl_add_u32 v5, v4, 4, v5
    s_add_u32 s28, s21, s22
    s_add_u32 s28, s28, s20
    s_lshl_b32 s28, s28, 11
    s_and_b32 s28, s28, 0x7fff
    v_add_u32 v48, s28, v5
    s_add_u32 s28, s28, 0x2000
    s_and_b32 s28, s28, 0x7fff
    v_add_u32 v49, s28, v5
    s_add_u32 s28, s28, 0x2000
    s_and_b32 s28, s28, 0x7fff
    v_add_u32 v50, s28, v5
    s_add_u32 s28, s28, 0x2000
    s_and_b32 s28, s28, 0x7fff
    v_add_u32 v51, s28, v5
    s_lshl_b32 s27, s21, 7
    s_add_u32 s27, s27, s22
    s_lshl_b32 s27, s27, 15
    v_mov_b32 v41, -1
    v_lshlrev_b32 v6, 2, v2
    ds_write_b32 v6, v41 offset:0
    v_mov_b32 v52, s42
    v_mov_b32 v53, 0x100000
    v_mov_b32 v46, 0
    ds_write_b64 v46, v[52:53] offset:264
    s_add_u32 s8, s8, s27
    s_addc_u32 s9, s9, 0
    v_and_b32 v41, 1, v2
    v_lshlrev_b32 v41, 4, v41
    v_mov_b32 v42, 0xffff
    v_lshlrev_b32 v41, v41, v42
    v_bfe_u32 v42, v2, 1, 2
    v_cmp_eq_u32 vcc, 0, v42
    v_mov_b32 v28, 0
    v_mov_b32 v29, 0
    v_cndmask_b32 v16, 0, v41, vcc
    v_cmp_eq_u32 vcc, 1, v42
    v_mov_b32 v30, 0
    v_mov_b32 v31, 0
    v_cndmask_b32 v17, 0, v41, vcc
    v_cmp_eq_u32 vcc, 2, v42
    v_mov_b32 v32, 0
    v_mov_b32 v33, 0
    v_cndmask_b32 v18, 0, v41, vcc
    v_cmp_eq_u32 vcc, 3, v42
    v_mov_b32 v34, 0
    v_mov_b32 v35, 0
    v_cndmask_b32 v19, 0, v41, vcc
    s_mov_b32 s26, 0x3db8aa3b
    v_mov_b32 v40, 0xff7f0000
    s_mov_b32 s25, 4
    v_lshlrev_b32 v5, 4, v4
    s_mov_b32 s50, 0
    v_mov_b32 v0, 1
    v_lshlrev_b32 v7, 3, v1
    s_mov_b32 s44, 0x10001
    s_mov_b32 s45, 0x10001
    s_mov_b32 s46, 0
    s_movk_i32 s47, 256
    v_lshlrev_b32 v45, 6, v1
    v_lshl_add_u32 v45, v3, 4, v45
    s_add_u32 s6, s6, s27
    s_addc_u32 s7, s7, 0
    s_mov_b32 s36, 4194304
    s_add_u32 m0, s34, 27648
    v_xor_b32 v11, 64, v11
    v_add_u32 v11, 7168, v11
    s_waitcnt vmcnt(6)
    s_mov_b64 exec, s[40:41]
    global_load_lds_dwordx4 v11, s[12:13] nt
    s_mov_b64 exec, -1
    s_waitcnt vmcnt(4)
    global_load_dwordx4 v[54:57], v48, s[6:7] nt
    s_waitcnt lgkmcnt(0)
    s_barrier
    s_waitcnt vmcnt(4)
    global_load_dwordx4 v[58:61], v48, s[6:7] offset:256 nt
    s_waitcnt vmcnt(4)
    global_load_dwordx4 v[62:65], v49, s[6:7] nt
    s_waitcnt vmcnt(4)
    global_load_dwordx4 v[66:69], v49, s[6:7] offset:256 nt
    s_waitcnt vmcnt(4)
    global_load_dwordx4 v[70:73], v50, s[6:7] nt
    s_waitcnt vmcnt(4)
    global_load_dwordx4 v[74:77], v50, s[6:7] offset:256 nt
    s_waitcnt vmcnt(4)
    global_load_dwordx4 v[78:81], v51, s[6:7] nt
    s_waitcnt vmcnt(4)
    global_load_dwordx4 v[82:85], v51, s[6:7] offset:256 nt
    s_add_u32 s6, s6, 0x40000
    s_addc_u32 s7, s7, 0
    s_waitcnt vmcnt(4)
    global_load_dwordx4 v[86:89], v48, s[6:7] nt
    s_waitcnt vmcnt(4)
    global_load_dwordx4 v[90:93], v48, s[6:7] offset:256 nt
    s_waitcnt vmcnt(4)
    global_load_dwordx4 v[94:97], v49, s[6:7] nt
    s_waitcnt vmcnt(4)
    global_load_dwordx4 v[98:101], v49, s[6:7] offset:256 nt
    s_waitcnt vmcnt(4)
    global_load_dwordx4 v[102:105], v50, s[6:7] nt
    s_waitcnt vmcnt(4)
    global_load_dwordx4 v[106:109], v50, s[6:7] offset:256 nt
    s_waitcnt vmcnt(4)
    global_load_dwordx4 v[110:113], v51, s[6:7] nt
    s_waitcnt vmcnt(4)
    global_load_dwordx4 v[114:117], v51, s[6:7] offset:256 nt
    s_add_u32 s6, s6, 0x40000
    s_addc_u32 s7, s7, 0
    s_waitcnt vmcnt(4)
    global_load_dwordx4 v[118:121], v48, s[6:7] nt
    s_waitcnt vmcnt(4)
    global_load_dwordx4 v[122:125], v48, s[6:7] offset:256 nt
    s_waitcnt vmcnt(4)
    global_load_dwordx4 v[126:129], v49, s[6:7] nt
    s_waitcnt vmcnt(4)
    global_load_dwordx4 v[130:133], v49, s[6:7] offset:256 nt
    s_waitcnt vmcnt(4)
    global_load_dwordx4 v[134:137], v50, s[6:7] nt
    s_waitcnt vmcnt(4)
    global_load_dwordx4 v[138:141], v50, s[6:7] offset:256 nt
    s_waitcnt vmcnt(4)
    global_load_dwordx4 v[142:145], v51, s[6:7] nt
    s_waitcnt vmcnt(4)
    global_load_dwordx4 v[146:149], v51, s[6:7] offset:256 nt
    s_add_u32 s6, s6, 0x40000
    s_addc_u32 s7, s7, 0
    s_waitcnt vmcnt(4)
    global_load_dwordx4 v[150:153], v48, s[6:7] nt
    s_waitcnt vmcnt(4)
    global_load_dwordx4 v[154:157], v48, s[6:7] offset:256 nt
    s_waitcnt vmcnt(4)
    global_load_dwordx4 v[158:161], v49, s[6:7] nt
    s_waitcnt vmcnt(4)
    global_load_dwordx4 v[162:165], v49, s[6:7] offset:256 nt
    s_waitcnt vmcnt(4)
    global_load_dwordx4 v[166:169], v50, s[6:7] nt
    s_waitcnt vmcnt(4)
    global_load_dwordx4 v[170:173], v50, s[6:7] offset:256 nt
    s_waitcnt vmcnt(4)
    global_load_dwordx4 v[174:177], v51, s[6:7] nt
    s_waitcnt vmcnt(4)
    global_load_dwordx4 v[178:181], v51, s[6:7] offset:256 nt
    s_add_u32 s6, s6, 0x40000
    s_addc_u32 s7, s7, 0
L_qw:
    ds_read_b32 v41, v46 offset:64
    ds_read_b128 v[8:11], v5 offset:512
    ds_read_b128 v[12:15], v5 offset:768
    s_sub_u32 s36, s36, 1
    s_cbranch_scc1 L_kloop
    s_waitcnt lgkmcnt(0)
    v_cmp_eq_u32 vcc, -1, v41
    s_cbranch_vccnz L_qw
L_kloop:
L_pad0:
    s_cbranch_execz L_pad1
    s_cmp_eq_u32 s25, 16
    s_cselect_b64 s[6:7], s[8:9], s[6:7]
    v_mov_b32 v36, 0
    v_dot2c_f32_bf16 v36, v54, v8
    v_dot2c_f32_bf16 v36, v55, v9
    v_dot2c_f32_bf16 v36, v56, v10
    v_dot2c_f32_bf16 v36, v57, v11
    s_waitcnt vmcnt(6)
    s_cmp_ge_i32 s50, 2
    s_cbranch_scc1 L_ok0_0_0
    s_waitcnt vmcnt(5)
    s_cmp_ge_i32 s50, 1
    s_cbranch_scc1 L_ok0_0_0
    s_waitcnt vmcnt(4)
L_ok0_0_0:
    global_load_dwordx4 v[54:57], v48, s[6:7] nt
    v_dot2c_f32_bf16 v36, v58, v12
    v_dot2c_f32_bf16 v36, v59, v13
    v_dot2c_f32_bf16 v36, v60, v14
    v_dot2c_f32_bf16 v36, v61, v15
    s_waitcnt vmcnt(6)
    s_cmp_ge_i32 s50, 2
    s_cbranch_scc1 L_ok0_0_1
    s_waitcnt vmcnt(5)
    s_cmp_ge_i32 s50, 1
    s_cbranch_scc1 L_ok0_0_1
    s_waitcnt vmcnt(4)
L_ok0_0_1:
    global_load_dwordx4 v[58:61], v48, s[6:7] offset:256 nt
    v_mov_b32 v37, 0
    v_dot2c_f32_bf16 v37, v62, v8
    v_dot2c_f32_bf16 v37, v63, v9
    v_dot2c_f32_bf16 v37, v64, v10
    v_dot2c_f32_bf16 v37, v65, v11
    s_waitcnt vmcnt(6)
    s_cmp_ge_i32 s50, 2
    s_cbranch_scc1 L_ok0_1_0
    s_waitcnt vmcnt(5)
    s_cmp_ge_i32 s50, 1
    s_cbranch_scc1 L_ok0_1_0
    s_waitcnt vmcnt(4)
L_ok0_1_0:
    global_load_dwordx4 v[62:65], v49, s[6:7] nt
    v_dot2c_f32_bf16 v37, v66, v12
    v_dot2c_f32_bf16 v37, v67, v13
    v_dot2c_f32_bf16 v37, v68, v14
    v_dot2c_f32_bf16 v37, v69, v15
    s_waitcnt vmcnt(6)
    s_cmp_ge_i32 s50, 2
    s_cbranch_scc1 L_ok0_1_1
    s_waitcnt vmcnt(5)
    s_cmp_ge_i32 s50, 1
    s_cbranch_scc1 L_ok0_1_1
    s_waitcnt vmcnt(4)
L_ok0_1_1:
    global_load_dwordx4 v[66:69], v49, s[6:7] offset:256 nt
    v_mov_b32 v38, 0
    v_dot2c_f32_bf16 v38, v70, v8
    v_dot2c_f32_bf16 v38, v71, v9
    v_dot2c_f32_bf16 v38, v72, v10
    v_dot2c_f32_bf16 v38, v73, v11
    s_waitcnt vmcnt(6)
L_pad1:
    s_cbranch_execz L_pad2
    s_cmp_ge_i32 s50, 2
    s_cbranch_scc1 L_ok0_2_0
    s_waitcnt vmcnt(5)
    s_cmp_ge_i32 s50, 1
    s_cbranch_scc1 L_ok0_2_0
    s_waitcnt vmcnt(4)
L_ok0_2_0:
    global_load_dwordx4 v[70:73], v50, s[6:7] nt
    v_dot2c_f32_bf16 v38, v74, v12
    v_dot2c_f32_bf16 v38, v75, v13
    v_dot2c_f32_bf16 v38, v76, v14
    v_dot2c_f32_bf16 v38, v77, v15
    s_waitcnt vmcnt(6)
    s_cmp_ge_i32 s50, 2
    s_cbranch_scc1 L_ok0_2_1
    s_waitcnt vmcnt(5)
    s_cmp_ge_i32 s50, 1
    s_cbranch_scc1 L_ok0_2_1
    s_waitcnt vmcnt(4)
L_ok0_2_1:
    global_load_dwordx4 v[74:77], v50, s[6:7] offset:256 nt
    s_memrealtime s[42:43]
    ds_read_b64 v[52:53], v46 offset:264
    v_mov_b32 v39, 0
    v_dot2c_f32_bf16 v39, v78, v8
    v_dot2c_f32_bf16 v39, v79, v9
    v_dot2c_f32_bf16 v39, v80, v10
    v_dot2c_f32_bf16 v39, v81, v11
    s_waitcnt vmcnt(6)
    s_cmp_ge_i32 s50, 2
    s_cbranch_scc1 L_ok0_3_0
    s_waitcnt vmcnt(5)
    s_cmp_ge_i32 s50, 1
    s_cbranch_scc1 L_ok0_3_0
    s_waitcnt vmcnt(4)
L_ok0_3_0:
    global_load_dwordx4 v[78:81], v51, s[6:7] nt
    v_dot2c_f32_bf16 v39, v82, v12
    v_dot2c_f32_bf16 v39, v83, v13
    v_dot2c_f32_bf16 v39, v84, v14
    v_dot2c_f32_bf16 v39, v85, v15
    s_waitcnt lgkmcnt(0)
    v_readfirstlane_b32 s48, v52
    v_readfirstlane_b32 s49, v53
    v_mov_b32 v52, s42
    v_mov_b32 v53, s25
    ds_write_b64 v7, v[52:53] offset:32
    s_sub_u32 s27, s42, s48
    s_lshl_b32 s27, s27, 4
    s_mul_i32 s28, s25, s49
    s_sub_u32 s27, s27, s28
    s_cmp_gt_i32 s27, 0
    s_cselect_b32 s50, 1, 0
    s_cmp_gt_i32 s27, 480
    s_cselect_b32 s50, 2, s50
    s_waitcnt vmcnt(6)
    s_cmp_ge_i32 s50, 2
    s_cbranch_scc1 L_ok0_3_1
    s_waitcnt vmcnt(5)
L_pad2:
    s_cbranch_execz L_pad3
    s_cmp_ge_i32 s50, 1
    s_cbranch_scc1 L_ok0_3_1
    s_waitcnt vmcnt(4)
L_ok0_3_1:
    global_load_dwordx4 v[82:85], v51, s[6:7] offset:256 nt
    v_add_f32_dpp v36, v36, v36 quad_perm:[1,0,3,2] row_mask:0xf bank_mask:0xf
    v_add_f32_dpp v37, v37, v37 quad_perm:[1,0,3,2] row_mask:0xf bank_mask:0xf
    v_add_f32_dpp v38, v38, v38 quad_perm:[1,0,3,2] row_mask:0xf bank_mask:0xf
    v_add_f32_dpp v39, v39, v39 quad_perm:[1,0,3,2] row_mask:0xf bank_mask:0xf
    v_add_f32_dpp v36, v36, v36 quad_perm:[2,3,0,1] row_mask:0xf bank_mask:0xf
    v_add_f32_dpp v37, v37, v37 quad_perm:[2,3,0,1] row_mask:0xf bank_mask:0xf
    v_add_f32_dpp v38, v38, v38 quad_perm:[2,3,0,1] row_mask:0xf bank_mask:0xf
    v_add_f32_dpp v39, v39, v39 quad_perm:[2,3,0,1] row_mask:0xf bank_mask:0xf
    v_add_f32_dpp v36, v36, v36 row_half_mirror row_mask:0xf bank_mask:0xf
    v_add_f32_dpp v37, v37, v37 row_half_mirror row_mask:0xf bank_mask:0xf
    v_add_f32_dpp v38, v38, v38 row_half_mirror row_mask:0xf bank_mask:0xf
    v_add_f32_dpp v39, v39, v39 row_half_mirror row_mask:0xf bank_mask:0xf
    v_add_f32_dpp v36, v36, v36 row_mirror row_mask:0xf bank_mask:0xf
    v_add_f32_dpp v37, v37, v37 row_mirror row_mask:0xf bank_mask:0xf
    v_add_f32_dpp v38, v38, v38 row_mirror row_mask:0xf bank_mask:0xf
    v_add_f32_dpp v39, v39, v39 row_mirror row_mask:0xf bank_mask:0xf
    v_add_u32 v41, s46, v45
    v_max3_f32 v40, v36, v37, v40
    v_max3_f32 v40, v38, v39, v40
    s_mov_b64 exec, s[44:45]
    ds_write_b128 v41, v[36:39] offset:6144
    s_mov_b64 exec, -1
    s_add_u32 s6, s6, 0x40000
    s_addc_u32 s7, s7, 0
    s_lshl_b32 s46, s25, 8
    s_add_u32 s25, s25, 1
    s_cmp_eq_u32 s25, 7
    s_cbranch_scc1 L_x3
L_xr0:
    v_mov_b32 v36, 0
    v_dot2c_f32_bf16 v36, v86, v8
    v_dot2c_f32_bf16 v36, v87, v9
    v_dot2c_f32_bf16 v36, v88, v10
    v_dot2c_f32_bf16 v36, v89, v11
    s_waitcnt vmcnt(6)
    s_cmp_ge_i32 s50, 2
    s_cbranch_scc1 L_ok1_0_0
    s_waitcnt vmcnt(5)
L_pad3:
    s_cbranch_execz L_pad4
    s_cmp_ge_i32 s50, 1
    s_cbranch_scc1 L_ok1_0_0
    s_waitcnt vmcnt(4)
L_ok1_0_0:
    global_load_dwordx4 v[86:89], v48, s[6:7] nt
    v_dot2c_f32_bf16 v36, v90, v12
    v_dot2c_f32_bf16 v36, v91, v13
    v_dot2c_f32_bf16 v36, v92, v14
    v_dot2c_f32_bf16 v36, v93, v15
    s_waitcnt vmcnt(6)
    s_cmp_ge_i32 s50, 2
    s_cbranch_scc1 L_ok1_0_1
    s_waitcnt vmcnt(5)
    s_cmp_ge_i32 s50, 1
    s_cbranch_scc1 L_ok1_0_1
    s_waitcnt vmcnt(4)
L_ok1_0_1:
    global_load_dwordx4 v[90:93], v48, s[6:7] offset:256 nt
    v_mov_b32 v37, 0
    v_dot2c_f32_bf16 v37, v94, v8
    v_dot2c_f32_bf16 v37, v95, v9
    v_dot2c_f32_bf16 v37, v96, v10
    v_dot2c_f32_bf16 v37, v97, v11
    s_waitcnt vmcnt(6)
    s_cmp_ge_i32 s50, 2
    s_cbranch_scc1 L_ok1_1_0
    s_waitcnt vmcnt(5)
    s_cmp_ge_i32 s50, 1
    s_cbranch_scc1 L_ok1_1_0
    s_waitcnt vmcnt(4)
L_ok1_1_0:
    global_load_dwordx4 v[94:97], v49, s[6:7] nt
    v_dot2c_f32_bf16 v37, v98, v12
    v_dot2c_f32_bf16 v37, v99, v13
    v_dot2c_f32_bf16 v37, v100, v14
    v_dot2c_f32_bf16 v37, v101, v15
    s_waitcnt vmcnt(6)
    s_cmp_ge_i32 s50, 2
    s_cbranch_scc1 L_ok1_1_1
    s_waitcnt vmcnt(5)
    s_cmp_ge_i32 s50, 1
    s_cbranch_scc1 L_ok1_1_1
    s_waitcnt vmcnt(4)
L_ok1_1_1:
    global_load_dwordx4 v[98:101], v49, s[6:7] offset:256 nt
    v_mov_b32 v38, 0
    v_dot2c_f32_bf16 v38, v102, v8
    v_dot2c_f32_bf16 v38, v103, v9
    v_dot2c_f32_bf16 v38, v104, v10
    v_dot2c_f32_bf16 v38, v105, v11
    s_waitcnt vmcnt(6)
    s_cmp_ge_i32 s50, 2
    s_cbranch_scc1 L_ok1_2_0
    s_waitcnt vmcnt(5)
    s_cmp_ge_i32 s50, 1
    s_cbranch_scc1 L_ok1_2_0
    s_waitcnt vmcnt(4)
L_ok1_2_0:
    global_load_dwordx4 v[102:105], v50, s[6:7] nt
    v_dot2c_f32_bf16 v38, v106, v12
    v_dot2c_f32_bf16 v38, v107, v13
    v_dot2c_f32_bf16 v38, v108, v14
L_pad4:
    s_cbranch_execz L_pad5
    v_dot2c_f32_bf16 v38, v109, v15
    s_waitcnt vmcnt(6)
    s_cmp_ge_i32 s50, 2
    s_cbranch_scc1 L_ok1_2_1
    s_waitcnt vmcnt(5)
    s_cmp_ge_i32 s50, 1
    s_cbranch_scc1 L_ok1_2_1
    s_waitcnt vmcnt(4)
L_ok1_2_1:
    global_load_dwordx4 v[106:109], v50, s[6:7] offset:256 nt
    s_memrealtime s[42:43]
    ds_read_b64 v[52:53], v46 offset:264
    v_mov_b32 v39, 0
    v_dot2c_f32_bf16 v39, v110, v8
    v_dot2c_f32_bf16 v39, v111, v9
    v_dot2c_f32_bf16 v39, v112, v10
    v_dot2c_f32_bf16 v39, v113, v11
    s_waitcnt vmcnt(6)
    s_cmp_ge_i32 s50, 2
    s_cbranch_scc1 L_ok1_3_0
    s_waitcnt vmcnt(5)
    s_cmp_ge_i32 s50, 1
    s_cbranch_scc1 L_ok1_3_0
    s_waitcnt vmcnt(4)
L_ok1_3_0:
    global_load_dwordx4 v[110:113], v51, s[6:7] nt
    v_dot2c_f32_bf16 v39, v114, v12
    v_dot2c_f32_bf16 v39, v115, v13
    v_dot2c_f32_bf16 v39, v116, v14
    v_dot2c_f32_bf16 v39, v117, v15
    s_waitcnt lgkmcnt(0)
    v_readfirstlane_b32 s48, v52
    v_readfirstlane_b32 s49, v53
    v_mov_b32 v52, s42
    v_mov_b32 v53, s25
    ds_write_b64 v7, v[52:53] offset:32
    s_sub_u32 s27, s42, s48
    s_lshl_b32 s27, s27, 4
    s_mul_i32 s28, s25, s49
    s_sub_u32 s27, s27, s28
    s_cmp_gt_i32 s27, 0
    s_cselect_b32 s50, 1, 0
    s_cmp_gt_i32 s27, 480
    s_cselect_b32 s50, 2, s50
    s_waitcnt vmcnt(6)
    s_cmp_ge_i32 s50, 2
    s_cbranch_scc1 L_ok1_3_1
    s_waitcnt vmcnt(5)
    s_cmp_ge_i32 s50, 1
    s_cbranch_scc1 L_ok1_3_1
    s_waitcnt vmcnt(4)
L_ok1_3_1:
    global_load_dwordx4 v[114:117], v51, s[6:7] offset:256 nt
    v_add_f32_dpp v36, v36, v36 quad_perm:[1,0,3,2] row_mask:0xf bank_mask:0xf
    v_add_f32_dpp v37, v37, v37 quad_perm:[1,0,3,2] row_mask:0xf bank_mask:0xf
    v_add_f32_dpp v38, v38, v38 quad_perm:[1,0,3,2] row_mask:0xf bank_mask:0xf
L_pad5:
    s_cbranch_execz L_pad6
    v_add_f32_dpp v39, v39, v39 quad_perm:[1,0,3,2] row_mask:0xf bank_mask:0xf
    v_add_f32_dpp v36, v36, v36 quad_perm:[2,3,0,1] row_mask:0xf bank_mask:0xf
    v_add_f32_dpp v37, v37, v37 quad_perm:[2,3,0,1] row_mask:0xf bank_mask:0xf
    v_add_f32_dpp v38, v38, v38 quad_perm:[2,3,0,1] row_mask:0xf bank_mask:0xf
    v_add_f32_dpp v39, v39, v39 quad_perm:[2,3,0,1] row_mask:0xf bank_mask:0xf
    v_add_f32_dpp v36, v36, v36 row_half_mirror row_mask:0xf bank_mask:0xf
    v_add_f32_dpp v37, v37, v37 row_half_mirror row_mask:0xf bank_mask:0xf
    v_add_f32_dpp v38, v38, v38 row_half_mirror row_mask:0xf bank_mask:0xf
    v_add_f32_dpp v39, v39, v39 row_half_mirror row_mask:0xf bank_mask:0xf
    v_add_f32_dpp v36, v36, v36 row_mirror row_mask:0xf bank_mask:0xf
    v_add_f32_dpp v37, v37, v37 row_mirror row_mask:0xf bank_mask:0xf
    v_add_f32_dpp v38, v38, v38 row_mirror row_mask:0xf bank_mask:0xf
    v_add_f32_dpp v39, v39, v39 row_mirror row_mask:0xf bank_mask:0xf
    v_add_u32 v41, s47, v45
    v_max3_f32 v40, v36, v37, v40
    v_max3_f32 v40, v38, v39, v40
    s_mov_b64 exec, s[44:45]
    ds_write_b128 v41, v[36:39] offset:6144
    s_mov_b64 exec, -1
    s_add_u32 s6, s6, 0x40000
    s_addc_u32 s7, s7, 0
    s_lshl_b32 s47, s25, 8
    s_add_u32 s25, s25, 1
    s_cmp_eq_u32 s25, 6
    s_cbranch_scc1 L_x2
L_xr1:
    s_cmp_lt_u32 s25, 18
    s_cbranch_scc1 L_kloop
    v_lshrrev_b32 v6, 2, v2
    v_lshlrev_b32 v6, 8, v6
    v_and_b32 v5, 3, v2
    v_lshl_add_u32 v6, v5, 4, v6
    v_lshl_add_u32 v6, v1, 6, v6
    v_mov_b32 v41, v40
    ds_read_b128 v[36:39], v6 offset:6144
    v_lshlrev_b32 v5, 2, v1
    v_permlane16_swap_b32 v40, v41
    v_max_f32 v42, v40, v41
    v_max_f32 v43, v40, v41
    v_lshrrev_b32 v11, 1, v3
    v_lshlrev_b32 v11, 9, v11
    v_permlane32_swap_b32 v42, v43
    v_max_f32 v40, v42, v43
L_pad6:
    s_cbranch_execz L_pad7
    v_cvt_pk_bf16_f32 v40, v40, v40
    v_lshlrev_b32 v40, 16, v40
    v_mul_f32 v40, s26, v40
    s_waitcnt lgkmcnt(0)
    ds_write_b32 v5, v40 offset:288
    v_cvt_pk_bf16_f32 v37, v36, v37
    v_cvt_pk_bf16_f32 v39, v38, v39
    v_lshlrev_b32 v36, 16, v37
    v_lshlrev_b32 v38, 16, v39
    v_and_b32 v37, 0xffff0000, v37
    v_and_b32 v39, 0xffff0000, v39
    v_fma_f32 v36, v36, s26, -v40
    v_fma_f32 v37, v37, s26, -v40
    v_fma_f32 v38, v38, s26, -v40
    v_fma_f32 v39, v39, s26, -v40
    v_exp_f32 v36, v36
    v_exp_f32 v37, v37
    v_exp_f32 v38, v38
    v_exp_f32 v39, v39
    s_nop 0
    ds_write_b128 v6, v[36:39] offset:6144
    ds_read_b128 v[36:39], v45 offset:6144
    ds_write_b32 v5, v0 offset:16
    v_lshl_add_u32 v11, v4, 5, v11
    v_and_b32 v5, 1, v3
    v_lshl_add_u32 v11, v5, 4, v11
    v_lshl_add_u32 v11, v1, 10, v11
    s_waitcnt lgkmcnt(1)
    v_cvt_pk_bf16_f32 v36, v36, v36
    v_cvt_pk_bf16_f32 v37, v37, v37
    v_cvt_pk_bf16_f32 v38, v38, v38
    v_cvt_pk_bf16_f32 v39, v39, v39
    v_and_b32 v20, v36, v16
    v_and_b32 v21, v36, v17
    v_and_b32 v22, v36, v18
    v_and_b32 v23, v36, v19
    s_nop 1
L_vloop:
    v_mfma_f32_16x16x32_bf16 v[28:31], v[20:23], v[54:57], v[28:31]
    v_mfma_f32_16x16x32_bf16 v[32:35], v[20:23], v[58:61], v[32:35]
    s_waitcnt vmcnt(6)
L_pad7:
    s_cbranch_execz L_pad8
    s_cmp_ge_i32 s50, 2
    s_cbranch_scc1 L_o0_0_0
    s_waitcnt vmcnt(5)
    s_cmp_ge_i32 s50, 1
    s_cbranch_scc1 L_o0_0_0
    s_waitcnt vmcnt(4)
L_o0_0_0:
    global_load_dwordx4 v[54:57], v48, s[6:7] nt
    v_and_b32 v24, v37, v16
    v_and_b32 v25, v37, v17
    v_and_b32 v26, v37, v18
    v_and_b32 v27, v37, v19
    s_waitcnt vmcnt(6)
    s_cmp_ge_i32 s50, 2
    s_cbranch_scc1 L_o0_0_1
    s_waitcnt vmcnt(5)
    s_cmp_ge_i32 s50, 1
    s_cbranch_scc1 L_o0_0_1
    s_waitcnt vmcnt(4)
L_o0_0_1:
    global_load_dwordx4 v[58:61], v48, s[6:7] offset:256 nt
    v_mfma_f32_16x16x32_bf16 v[28:31], v[24:27], v[62:65], v[28:31]
    v_mfma_f32_16x16x32_bf16 v[32:35], v[24:27], v[66:69], v[32:35]
    s_waitcnt vmcnt(6)
    s_cmp_ge_i32 s50, 2
    s_cbranch_scc1 L_o0_1_0
    s_waitcnt vmcnt(5)
    s_cmp_ge_i32 s50, 1
    s_cbranch_scc1 L_o0_1_0
    s_waitcnt vmcnt(4)
L_o0_1_0:
    global_load_dwordx4 v[62:65], v49, s[6:7] nt
    v_and_b32 v20, v38, v16
    v_and_b32 v21, v38, v17
    v_and_b32 v22, v38, v18
    v_and_b32 v23, v38, v19
    s_waitcnt vmcnt(6)
    s_cmp_ge_i32 s50, 2
    s_cbranch_scc1 L_o0_1_1
    s_waitcnt vmcnt(5)
    s_cmp_ge_i32 s50, 1
    s_cbranch_scc1 L_o0_1_1
    s_waitcnt vmcnt(4)
L_o0_1_1:
    global_load_dwordx4 v[66:69], v49, s[6:7] offset:256 nt
    v_mfma_f32_16x16x32_bf16 v[28:31], v[20:23], v[70:73], v[28:31]
    v_mfma_f32_16x16x32_bf16 v[32:35], v[20:23], v[74:77], v[32:35]
    s_waitcnt vmcnt(6)
    s_cmp_ge_i32 s50, 2
    s_cbranch_scc1 L_o0_2_0
    s_waitcnt vmcnt(5)
    s_cmp_ge_i32 s50, 1
    s_cbranch_scc1 L_o0_2_0
    s_waitcnt vmcnt(4)
L_o0_2_0:
    global_load_dwordx4 v[70:73], v50, s[6:7] nt
    v_and_b32 v24, v39, v16
    v_and_b32 v25, v39, v17
L_pad8:
    s_cbranch_execz L_pad9
    v_and_b32 v26, v39, v18
    v_and_b32 v27, v39, v19
    s_waitcnt vmcnt(6)
    s_cmp_ge_i32 s50, 2
    s_cbranch_scc1 L_o0_2_1
    s_waitcnt vmcnt(5)
    s_cmp_ge_i32 s50, 1
    s_cbranch_scc1 L_o0_2_1
    s_waitcnt vmcnt(4)
L_o0_2_1:
    global_load_dwordx4 v[74:77], v50, s[6:7] offset:256 nt
    s_memrealtime s[42:43]
    ds_read_b64 v[52:53], v46 offset:264
    v_add_u32 v45, 256, v45
    ds_read_b128 v[36:39], v45 offset:6144
    v_mfma_f32_16x16x32_bf16 v[28:31], v[24:27], v[78:81], v[28:31]
    v_mfma_f32_16x16x32_bf16 v[32:35], v[24:27], v[82:85], v[32:35]
    s_waitcnt vmcnt(6)
    s_cmp_ge_i32 s50, 2
    s_cbranch_scc1 L_o0_3_0
    s_waitcnt vmcnt(5)
    s_cmp_ge_i32 s50, 1
    s_cbranch_scc1 L_o0_3_0
    s_waitcnt vmcnt(4)
L_o0_3_0:
    global_load_dwordx4 v[78:81], v51, s[6:7] nt
    s_waitcnt lgkmcnt(0)
    v_cvt_pk_bf16_f32 v36, v36, v36
    v_cvt_pk_bf16_f32 v37, v37, v37
    v_cvt_pk_bf16_f32 v38, v38, v38
    v_cvt_pk_bf16_f32 v39, v39, v39
    v_readfirstlane_b32 s48, v52
    v_readfirstlane_b32 s49, v53
    v_mov_b32 v52, s42
    v_mov_b32 v53, s25
    ds_write_b64 v7, v[52:53] offset:32
    s_sub_u32 s27, s42, s48
    s_lshl_b32 s27, s27, 4
    s_mul_i32 s28, s25, s49
    s_sub_u32 s27, s27, s28
    s_cmp_gt_i32 s27, 0
    s_cselect_b32 s50, 1, 0
    s_cmp_gt_i32 s27, 480
    s_cselect_b32 s50, 2, s50
    v_and_b32 v20, v36, v16
    v_and_b32 v21, v36, v17
    v_and_b32 v22, v36, v18
    v_and_b32 v23, v36, v19
    s_waitcnt vmcnt(6)
    s_cmp_ge_i32 s50, 2
    s_cbranch_scc1 L_o0_3_1
    s_waitcnt vmcnt(5)
L_pad9:
    s_cbranch_execz L_pad10
    s_cmp_ge_i32 s50, 1
    s_cbranch_scc1 L_o0_3_1
    s_waitcnt vmcnt(4)
L_o0_3_1:
    global_load_dwordx4 v[82:85], v51, s[6:7] offset:256 nt
    s_add_u32 s6, s6, 0x40000
    s_addc_u32 s7, s7, 0
    s_add_u32 s25, s25, 1
    v_mfma_f32_16x16x32_bf16 v[28:31], v[20:23], v[86:89], v[28:31]
    v_mfma_f32_16x16x32_bf16 v[32:35], v[20:23], v[90:93], v[32:35]
    s_waitcnt vmcnt(6)
    s_cmp_ge_i32 s50, 2
    s_cbranch_scc1 L_o1_0_0
    s_waitcnt vmcnt(5)
    s_cmp_ge_i32 s50, 1
    s_cbranch_scc1 L_o1_0_0
    s_waitcnt vmcnt(4)
L_o1_0_0:
    global_load_dwordx4 v[86:89], v48, s[6:7] nt
    v_and_b32 v24, v37, v16
    v_and_b32 v25, v37, v17
    v_and_b32 v26, v37, v18
    v_and_b32 v27, v37, v19
    s_waitcnt vmcnt(6)
    s_cmp_ge_i32 s50, 2
    s_cbranch_scc1 L_o1_0_1
    s_waitcnt vmcnt(5)
    s_cmp_ge_i32 s50, 1
    s_cbranch_scc1 L_o1_0_1
    s_waitcnt vmcnt(4)
L_o1_0_1:
    global_load_dwordx4 v[90:93], v48, s[6:7] offset:256 nt
    v_mfma_f32_16x16x32_bf16 v[28:31], v[24:27], v[94:97], v[28:31]
    v_mfma_f32_16x16x32_bf16 v[32:35], v[24:27], v[98:101], v[32:35]
    s_waitcnt vmcnt(6)
    s_cmp_ge_i32 s50, 2
    s_cbranch_scc1 L_o1_1_0
    s_waitcnt vmcnt(5)
    s_cmp_ge_i32 s50, 1
    s_cbranch_scc1 L_o1_1_0
    s_waitcnt vmcnt(4)
L_o1_1_0:
    global_load_dwordx4 v[94:97], v49, s[6:7] nt
    v_and_b32 v20, v38, v16
    v_and_b32 v21, v38, v17
    v_and_b32 v22, v38, v18
    v_and_b32 v23, v38, v19
    s_waitcnt vmcnt(6)
    s_cmp_ge_i32 s50, 2
    s_cbranch_scc1 L_o1_1_1
    s_waitcnt vmcnt(5)
    s_cmp_ge_i32 s50, 1
    s_cbranch_scc1 L_o1_1_1
    s_waitcnt vmcnt(4)
L_o1_1_1:
    global_load_dwordx4 v[98:101], v49, s[6:7] offset:256 nt
    v_mfma_f32_16x16x32_bf16 v[28:31], v[20:23], v[102:105], v[28:31]
L_pad10:
    s_cbranch_execz L_pad11
    v_mfma_f32_16x16x32_bf16 v[32:35], v[20:23], v[106:109], v[32:35]
    s_waitcnt vmcnt(6)
    s_cmp_ge_i32 s50, 2
    s_cbranch_scc1 L_o1_2_0
    s_waitcnt vmcnt(5)
    s_cmp_ge_i32 s50, 1
    s_cbranch_scc1 L_o1_2_0
    s_waitcnt vmcnt(4)
L_o1_2_0:
    global_load_dwordx4 v[102:105], v50, s[6:7] nt
    v_and_b32 v24, v39, v16
    v_and_b32 v25, v39, v17
    v_and_b32 v26, v39, v18
    v_and_b32 v27, v39, v19
    s_waitcnt vmcnt(6)
    s_cmp_ge_i32 s50, 2
    s_cbranch_scc1 L_o1_2_1
    s_waitcnt vmcnt(5)
    s_cmp_ge_i32 s50, 1
    s_cbranch_scc1 L_o1_2_1
    s_waitcnt vmcnt(4)
L_o1_2_1:
    global_load_dwordx4 v[106:109], v50, s[6:7] offset:256 nt
    s_memrealtime s[42:43]
    ds_read_b64 v[52:53], v46 offset:264
    v_add_u32 v45, 256, v45
    ds_read_b128 v[36:39], v45 offset:6144
    v_mfma_f32_16x16x32_bf16 v[28:31], v[24:27], v[110:113], v[28:31]
    v_mfma_f32_16x16x32_bf16 v[32:35], v[24:27], v[114:117], v[32:35]
    s_waitcnt vmcnt(6)
    s_cmp_ge_i32 s50, 2
    s_cbranch_scc1 L_o1_3_0
    s_waitcnt vmcnt(5)
    s_cmp_ge_i32 s50, 1
    s_cbranch_scc1 L_o1_3_0
    s_waitcnt vmcnt(4)
L_o1_3_0:
    global_load_dwordx4 v[110:113], v51, s[6:7] nt
    s_waitcnt lgkmcnt(0)
    v_cvt_pk_bf16_f32 v36, v36, v36
    v_cvt_pk_bf16_f32 v37, v37, v37
    v_cvt_pk_bf16_f32 v38, v38, v38
    v_cvt_pk_bf16_f32 v39, v39, v39
    v_readfirstlane_b32 s48, v52
    v_readfirstlane_b32 s49, v53
    v_mov_b32 v52, s42
    v_mov_b32 v53, s25
    ds_write_b64 v7, v[52:53] offset:32
    s_sub_u32 s27, s42, s48
    s_lshl_b32 s27, s27, 4
    s_mul_i32 s28, s25, s49
L_pad11:
    s_cbranch_execz L_pad12
    s_sub_u32 s27, s27, s28
    s_cmp_gt_i32 s27, 0
    s_cselect_b32 s50, 1, 0
    s_cmp_gt_i32 s27, 480
    s_cselect_b32 s50, 2, s50
    v_and_b32 v20, v36, v16
    v_and_b32 v21, v36, v17
    v_and_b32 v22, v36, v18
    v_and_b32 v23, v36, v19
    s_waitcnt vmcnt(6)
    s_cmp_ge_i32 s50, 2
    s_cbranch_scc1 L_o1_3_1
    s_waitcnt vmcnt(5)
    s_cmp_ge_i32 s50, 1
    s_cbranch_scc1 L_o1_3_1
    s_waitcnt vmcnt(4)
L_o1_3_1:
    global_load_dwordx4 v[114:117], v51, s[6:7] offset:256 nt
    s_add_u32 s6, s6, 0x40000
    s_addc_u32 s7, s7, 0
    s_add_u32 s25, s25, 1
    s_cmp_lt_u32 s25, 32
    s_cbranch_scc1 L_vloop
    s_waitcnt vmcnt(14)
    v_mfma_f32_16x16x32_bf16 v[28:31], v[20:23], v[54:57], v[28:31]
    v_mfma_f32_16x16x32_bf16 v[32:35], v[20:23], v[58:61], v[32:35]
    v_and_b32 v24, v37, v16
    v_and_b32 v25, v37, v17
    v_and_b32 v26, v37, v18
    v_and_b32 v27, v37, v19
    s_nop 0
    s_waitcnt vmcnt(12)
    v_mfma_f32_16x16x32_bf16 v[28:31], v[24:27], v[62:65], v[28:31]
    v_mfma_f32_16x16x32_bf16 v[32:35], v[24:27], v[66:69], v[32:35]
    v_and_b32 v20, v38, v16
    v_and_b32 v21, v38, v17
    v_and_b32 v22, v38, v18
    v_and_b32 v23, v38, v19
    s_nop 0
    s_waitcnt vmcnt(10)
    v_mfma_f32_16x16x32_bf16 v[28:31], v[20:23], v[70:73], v[28:31]
    v_mfma_f32_16x16x32_bf16 v[32:35], v[20:23], v[74:77], v[32:35]
    v_and_b32 v24, v39, v16
    v_and_b32 v25, v39, v17
    v_and_b32 v26, v39, v18
    v_and_b32 v27, v39, v19
    ds_read_b128 v[36:39], v45 offset:6400
    s_waitcnt vmcnt(8)
    v_mfma_f32_16x16x32_bf16 v[28:31], v[24:27], v[78:81], v[28:31]
    v_mfma_f32_16x16x32_bf16 v[32:35], v[24:27], v[82:85], v[32:35]
    s_waitcnt lgkmcnt(0)
    v_cvt_pk_bf16_f32 v36, v36, v36
L_pad12:
    s_cbranch_execz L_pad13
    v_cvt_pk_bf16_f32 v37, v37, v37
    v_cvt_pk_bf16_f32 v38, v38, v38
    v_cvt_pk_bf16_f32 v39, v39, v39
    v_and_b32 v54, v36, v16
    v_and_b32 v55, v36, v17
    v_and_b32 v56, v36, v18
    v_and_b32 v57, v36, v19
    v_and_b32 v58, v37, v16
    v_and_b32 v59, v37, v17
    v_and_b32 v60, v37, v18
    v_and_b32 v61, v37, v19
    v_and_b32 v62, v38, v16
    v_and_b32 v63, v38, v17
    v_and_b32 v64, v38, v18
    v_and_b32 v65, v38, v19
    v_and_b32 v66, v39, v16
    v_and_b32 v67, v39, v17
    v_and_b32 v68, v39, v18
    v_and_b32 v69, v39, v19
    s_waitcnt vmcnt(6)
    v_mfma_f32_16x16x32_bf16 v[28:31], v[54:57], v[86:89], v[28:31]
    v_mfma_f32_16x16x32_bf16 v[32:35], v[54:57], v[90:93], v[32:35]
    s_waitcnt vmcnt(4)
    v_mfma_f32_16x16x32_bf16 v[28:31], v[58:61], v[94:97], v[28:31]
    v_mfma_f32_16x16x32_bf16 v[32:35], v[58:61], v[98:101], v[32:35]
    s_waitcnt vmcnt(2)
    v_mfma_f32_16x16x32_bf16 v[28:31], v[62:65], v[102:105], v[28:31]
    v_mfma_f32_16x16x32_bf16 v[32:35], v[62:65], v[106:109], v[32:35]
    s_waitcnt vmcnt(1)
    v_mfma_f32_16x16x32_bf16 v[28:31], v[66:69], v[110:113], v[28:31]
    s_waitcnt vmcnt(0)
    v_mfma_f32_16x16x32_bf16 v[32:35], v[66:69], v[114:117], v[32:35]
    s_mov_b32 exec_hi, 0
    s_nop 4
    ds_write_b128 v11, v[28:31] offset:2048
    s_not_b64 exec, exec
    ds_write_b128 v11, v[32:35] offset:2048
    s_waitcnt lgkmcnt(0)
    s_barrier
    s_endpgm
L_x2:
    v_mov_b32 v36, 0
    v_dot2c_f32_bf16 v36, v118, v8
    v_dot2c_f32_bf16 v36, v119, v9
    v_dot2c_f32_bf16 v36, v120, v10
    v_dot2c_f32_bf16 v36, v121, v11
    v_dot2c_f32_bf16 v36, v122, v12
    v_dot2c_f32_bf16 v36, v123, v13
    v_dot2c_f32_bf16 v36, v124, v14
    v_dot2c_f32_bf16 v36, v125, v15
L_pad13:
    s_cbranch_execz L_pad14
    v_mov_b32 v37, 0
    v_dot2c_f32_bf16 v37, v126, v8
    v_dot2c_f32_bf16 v37, v127, v9
    v_dot2c_f32_bf16 v37, v128, v10
    v_dot2c_f32_bf16 v37, v129, v11
    v_dot2c_f32_bf16 v37, v130, v12
    v_dot2c_f32_bf16 v37, v131, v13
    v_dot2c_f32_bf16 v37, v132, v14
    v_dot2c_f32_bf16 v37, v133, v15
    v_mov_b32 v38, 0
    v_dot2c_f32_bf16 v38, v134, v8
    v_dot2c_f32_bf16 v38, v135, v9
    v_dot2c_f32_bf16 v38, v136, v10
    v_dot2c_f32_bf16 v38, v137, v11
    v_dot2c_f32_bf16 v38, v138, v12
    v_dot2c_f32_bf16 v38, v139, v13
    v_dot2c_f32_bf16 v38, v140, v14
    v_dot2c_f32_bf16 v38, v141, v15
    v_mov_b32 v39, 0
    v_dot2c_f32_bf16 v39, v142, v8
    v_dot2c_f32_bf16 v39, v143, v9
    v_dot2c_f32_bf16 v39, v144, v10
    v_dot2c_f32_bf16 v39, v145, v11
    v_dot2c_f32_bf16 v39, v146, v12
    v_dot2c_f32_bf16 v39, v147, v13
    v_dot2c_f32_bf16 v39, v148, v14
    v_dot2c_f32_bf16 v39, v149, v15
    v_add_f32_dpp v36, v36, v36 quad_perm:[1,0,3,2] row_mask:0xf bank_mask:0xf
    v_add_f32_dpp v37, v37, v37 quad_perm:[1,0,3,2] row_mask:0xf bank_mask:0xf
    v_add_f32_dpp v38, v38, v38 quad_perm:[1,0,3,2] row_mask:0xf bank_mask:0xf
    v_add_f32_dpp v39, v39, v39 quad_perm:[1,0,3,2] row_mask:0xf bank_mask:0xf
    v_add_f32_dpp v36, v36, v36 quad_perm:[2,3,0,1] row_mask:0xf bank_mask:0xf
    v_add_f32_dpp v37, v37, v37 quad_perm:[2,3,0,1] row_mask:0xf bank_mask:0xf
    v_add_f32_dpp v38, v38, v38 quad_perm:[2,3,0,1] row_mask:0xf bank_mask:0xf
    v_add_f32_dpp v39, v39, v39 quad_perm:[2,3,0,1] row_mask:0xf bank_mask:0xf
    v_add_f32_dpp v36, v36, v36 row_half_mirror row_mask:0xf bank_mask:0xf
    v_add_f32_dpp v37, v37, v37 row_half_mirror row_mask:0xf bank_mask:0xf
    v_add_f32_dpp v38, v38, v38 row_half_mirror row_mask:0xf bank_mask:0xf
    v_add_f32_dpp v39, v39, v39 row_half_mirror row_mask:0xf bank_mask:0xf
    v_add_f32_dpp v36, v36, v36 row_mirror row_mask:0xf bank_mask:0xf
    v_add_f32_dpp v37, v37, v37 row_mirror row_mask:0xf bank_mask:0xf
    v_add_f32_dpp v38, v38, v38 row_mirror row_mask:0xf bank_mask:0xf
    v_add_f32_dpp v39, v39, v39 row_mirror row_mask:0xf bank_mask:0xf
    v_max3_f32 v40, v36, v37, v40
    v_max3_f32 v40, v38, v39, v40
L_pad14:
    s_cbranch_execz L_pad15
    s_mov_b64 exec, s[44:45]
    ds_write_b128 v45, v[36:39] offset:6656
    s_mov_b64 exec, -1
    s_branch L_xr1
L_x3:
    v_mov_b32 v36, 0
    v_dot2c_f32_bf16 v36, v150, v8
    v_dot2c_f32_bf16 v36, v151, v9
    v_dot2c_f32_bf16 v36, v152, v10
    v_dot2c_f32_bf16 v36, v153, v11
    v_dot2c_f32_bf16 v36, v154, v12
    v_dot2c_f32_bf16 v36, v155, v13
    v_dot2c_f32_bf16 v36, v156, v14
    v_dot2c_f32_bf16 v36, v157, v15
    v_mov_b32 v37, 0
    v_dot2c_f32_bf16 v37, v158, v8
    v_dot2c_f32_bf16 v37, v159, v9
    v_dot2c_f32_bf16 v37, v160, v10
    v_dot2c_f32_bf16 v37, v161, v11
    v_dot2c_f32_bf16 v37, v162, v12
    v_dot2c_f32_bf16 v37, v163, v13
    v_dot2c_f32_bf16 v37, v164, v14
    v_dot2c_f32_bf16 v37, v165, v15
    v_mov_b32 v38, 0
    v_dot2c_f32_bf16 v38, v166, v8
    v_dot2c_f32_bf16 v38, v167, v9
    v_dot2c_f32_bf16 v38, v168, v10
    v_dot2c_f32_bf16 v38, v169, v11
    v_dot2c_f32_bf16 v38, v170, v12
    v_dot2c_f32_bf16 v38, v171, v13
    v_dot2c_f32_bf16 v38, v172, v14
    v_dot2c_f32_bf16 v38, v173, v15
    v_mov_b32 v39, 0
    v_dot2c_f32_bf16 v39, v174, v8
    v_dot2c_f32_bf16 v39, v175, v9
    v_dot2c_f32_bf16 v39, v176, v10
    v_dot2c_f32_bf16 v39, v177, v11
    v_dot2c_f32_bf16 v39, v178, v12
    v_dot2c_f32_bf16 v39, v179, v13
    v_dot2c_f32_bf16 v39, v180, v14
    v_dot2c_f32_bf16 v39, v181, v15
    v_add_f32_dpp v36, v36, v36 quad_perm:[1,0,3,2] row_mask:0xf bank_mask:0xf
    v_add_f32_dpp v37, v37, v37 quad_perm:[1,0,3,2] row_mask:0xf bank_mask:0xf
    v_add_f32_dpp v38, v38, v38 quad_perm:[1,0,3,2] row_mask:0xf bank_mask:0xf
    v_add_f32_dpp v39, v39, v39 quad_perm:[1,0,3,2] row_mask:0xf bank_mask:0xf
    v_add_f32_dpp v36, v36, v36 quad_perm:[2,3,0,1] row_mask:0xf bank_mask:0xf
    v_add_f32_dpp v37, v37, v37 quad_perm:[2,3,0,1] row_mask:0xf bank_mask:0xf
    v_add_f32_dpp v38, v38, v38 quad_perm:[2,3,0,1] row_mask:0xf bank_mask:0xf
    v_add_f32_dpp v39, v39, v39 quad_perm:[2,3,0,1] row_mask:0xf bank_mask:0xf
    v_add_f32_dpp v36, v36, v36 row_half_mirror row_mask:0xf bank_mask:0xf
    v_add_f32_dpp v37, v37, v37 row_half_mirror row_mask:0xf bank_mask:0xf
    v_add_f32_dpp v38, v38, v38 row_half_mirror row_mask:0xf bank_mask:0xf
L_pad15:
    s_cbranch_execz L_pad16
    v_add_f32_dpp v39, v39, v39 row_half_mirror row_mask:0xf bank_mask:0xf
    v_add_f32_dpp v36, v36, v36 row_mirror row_mask:0xf bank_mask:0xf
    v_add_f32_dpp v37, v37, v37 row_mirror row_mask:0xf bank_mask:0xf
    v_add_f32_dpp v38, v38, v38 row_mirror row_mask:0xf bank_mask:0xf
    v_add_f32_dpp v39, v39, v39 row_mirror row_mask:0xf bank_mask:0xf
    v_max3_f32 v40, v36, v37, v40
    v_max3_f32 v40, v38, v39, v40
    s_mov_b64 exec, s[44:45]
    ds_write_b128 v45, v[36:39] offset:6912
    s_mov_b64 exec, -1
    s_branch L_xr0
L_helper:
    s_lshr_b32 s34, s2, 3
    v_lshrrev_b32 v5, 3, v2
    v_and_b32 v7, 7, v2
    s_cmp_eq_u32 s20, 4
    s_cbranch_scc1 L_isq
    s_cmp_eq_u32 s20, 7
    s_cbranch_scc1 L_w7
    s_barrier
    s_branch L_hwait
L_w7:
    s_getpc_b64 s[40:41]
L_pc:
    s_sub_u32 s40, s40, L_pc-standalone__mha_block_cached__decode_kernel
    s_subb_u32 s41, s41, 0
    v_lshlrev_b32 v6, 6, v2
    global_load_dword v10, v6, s[40:41]
    v_add_u32 v6, 0x1000, v6
    v_min_u32 v9, L_last-standalone__mha_block_cached__decode_kernel, v6
    global_load_dword v10, v9, s[40:41]
    v_add_u32 v6, 0x1000, v6
    v_min_u32 v9, L_last-standalone__mha_block_cached__decode_kernel, v6
    global_load_dword v10, v9, s[40:41]
    s_lshl3_add_u32 s28, s21, s22
    s_lshl_b32 s28, s28, 10
    s_add_u32 s28, s28, 524288
    v_lshl_add_u32 v9, v2, 4, s28
    s_waitcnt lgkmcnt(0)
    global_load_dword v10, v9, s[18:19]
    s_lshl_b32 s27, s21, 22
    v_and_b32 v9, 1, v2
    v_lshlrev_b32 v9, 21, v9
    v_add_u32 v9, s27, v9
    global_load_dword v10, v9, s[6:7] nt
    global_load_dword v10, v9, s[8:9] nt
    s_lshr_b32 s38, s21, 4
    s_lshl3_add_u32 s28, s38, s22
    s_lshl_b32 s28, s28, 8
    s_lshl_b32 s27, s37, 13
    s_add_u32 s28, s28, s27
    s_add_u32 s28, s28, 262144
    v_lshrrev_b32 v9, 5, v2
    v_lshlrev_b32 v9, 12, v9
    v_lshl_add_u32 v9, v4, 4, v9
    v_add_u32 v9, s28, v9
    global_load_dword v10, v9, s[18:19]
    s_lshl_b32 s27, s23, 8
    s_add_u32 s27, s27, 4096
    v_lshl_add_u32 v9, v2, 2, s27
    global_load_dword v10, v9, s[18:19]
    s_and_b32 s27, s34, 3
    s_lshl2_add_u32 s27, s23, s27
    s_lshl_b32 s28, s22, 7
    s_add_u32 s27, s27, s28
    s_lshl_b32 s27, s27, 7
    s_add_u32 s27, s27, 786432
    v_lshlrev_b32 v9, 12, v3
    v_lshl_add_u32 v9, v4, 3, v9
    v_add_u32 v9, s27, v9
    global_load_dword v10, v9, s[18:19]
    s_barrier
    s_waitcnt vmcnt(0)
    s_mov_b64 exec, 0
    s_branch L_pad0
L_isq:
    s_setprio 3
    s_lshr_b32 s38, s21, 4
    s_lshr_b32 s28, s22, 2
    s_lshl1_add_u32 s24, s38, s28
    s_mul_i32 s27, s24, 112
    s_and_b32 s25, s22, 3
    v_and_b32 v6, 1, v2
    v_mul_u32_u24 v6, 896, v6
    v_lshl_add_u32 v6, v3, 3, v6
    s_lshl_b32 s27, s27, 1
    v_add_u32 v6, s27, v6
    s_waitcnt lgkmcnt(0)
    s_load_dword s33, s[18:19], 0
    global_load_dwordx2 v[16:17], v6, s[4:5] offset:0
    global_load_dwordx2 v[18:19], v6, s[4:5] offset:32
    global_load_dwordx2 v[20:21], v6, s[4:5] offset:64
    global_load_dwordx2 v[22:23], v6, s[4:5] offset:96
    global_load_dwordx2 v[24:25], v6, s[4:5] offset:128
    global_load_dwordx2 v[26:27], v6, s[4:5] offset:160
    global_load_dwordx2 v[28:29], v6, s[4:5] offset:192
    v_lshrrev_b32 v7, 2, v2
    v_lshlrev_b32 v7, 7, v7
    v_and_b32 v8, 3, v2
    v_lshl_add_u32 v7, v8, 3, v7
    s_lshl_b32 s27, s37, 13
    s_lshl_b32 s28, s24, 10
    s_add_u32 s28, s28, s27
    s_lshl_b32 s25, s25, 8
    s_add_u32 s28, s28, s25
    s_add_u32 s28, s28, 264192
    v_lshl_add_u32 v8, v2, 2, s28
    s_lshl_b32 s28, s38, 12
    s_add_u32 s27, s27, s28
    s_add_u32 s27, s27, 262144
    v_lshl_add_u32 v9, v2, 4, s27
    s_lshl_b32 s27, s23, 8
    s_add_u32 s27, s27, 4096
    v_and_b32 v14, 31, v2
    v_lshl_add_u32 v14, v14, 2, s27
    s_lshl2_add_u32 s27, s34, s27
    v_mov_b32 v12, s27
    s_getreg_b32 s31, hwreg(HW_REG_XCC_ID, 0, 4)
    s_lshl_b32 s31, s31, 28
    s_waitcnt lgkmcnt(0)
    s_add_u32 s33, s33, 1
    s_xor_b32 s31, s31, s33
    v_mov_b32 v13, s31
    global_store_dword v12, v13, s[18:19]
    s_and_b32 s32, s33, 15
    v_mov_b32 v10, s32
    s_movk_i32 s26, 15
    s_barrier
    s_waitcnt vmcnt(1)
    ds_read_b64_tr_b16 v[48:49], v7 offset:10240
    ds_read_b64_tr_b16 v[50:51], v7 offset:10272
    ds_read_b64_tr_b16 v[52:53], v7 offset:10304
    ds_read_b64_tr_b16 v[54:55], v7 offset:10336
    ds_read_b64_tr_b16 v[56:57], v7 offset:12288
    ds_read_b64_tr_b16 v[58:59], v7 offset:12320
    ds_read_b64_tr_b16 v[60:61], v7 offset:12352
    ds_read_b64_tr_b16 v[62:63], v7 offset:12384
    ds_read_b64_tr_b16 v[64:65], v7 offset:14336
    ds_read_b64_tr_b16 v[66:67], v7 offset:14368
    ds_read_b64_tr_b16 v[68:69], v7 offset:14400
    ds_read_b64_tr_b16 v[70:71], v7 offset:14432
    s_waitcnt lgkmcnt(8)
    ds_read_b64_tr_b16 v[72:73], v7 offset:16384
    ds_read_b64_tr_b16 v[74:75], v7 offset:16416
    ds_read_b64_tr_b16 v[76:77], v7 offset:16448
    ds_read_b64_tr_b16 v[78:79], v7 offset:16480
    v_mfma_f32_16x16x16_bf16 v[32:35], v[16:17], v[48:49], 0
    v_mfma_f32_16x16x16_bf16 v[36:39], v[16:17], v[50:51], 0
    v_mfma_f32_16x16x16_bf16 v[40:43], v[16:17], v[52:53], 0
    v_mfma_f32_16x16x16_bf16 v[44:47], v[16:17], v[54:55], 0
    s_waitcnt lgkmcnt(8)
    ds_read_b64_tr_b16 v[80:81], v7 offset:18432
    ds_read_b64_tr_b16 v[82:83], v7 offset:18464
    ds_read_b64_tr_b16 v[84:85], v7 offset:18496
    ds_read_b64_tr_b16 v[86:87], v7 offset:18528
    v_mfma_f32_16x16x16_bf16 v[32:35], v[18:19], v[56:57], v[32:35]
    v_mfma_f32_16x16x16_bf16 v[36:39], v[18:19], v[58:59], v[36:39]
    v_mfma_f32_16x16x16_bf16 v[40:43], v[18:19], v[60:61], v[40:43]
    v_mfma_f32_16x16x16_bf16 v[44:47], v[18:19], v[62:63], v[44:47]
    s_waitcnt lgkmcnt(8)
    ds_read_b64_tr_b16 v[88:89], v7 offset:20480
    ds_read_b64_tr_b16 v[90:91], v7 offset:20512
    ds_read_b64_tr_b16 v[92:93], v7 offset:20544
    ds_read_b64_tr_b16 v[94:95], v7 offset:20576
    v_mfma_f32_16x16x16_bf16 v[32:35], v[20:21], v[64:65], v[32:35]
    v_mfma_f32_16x16x16_bf16 v[36:39], v[20:21], v[66:67], v[36:39]
    v_mfma_f32_16x16x16_bf16 v[40:43], v[20:21], v[68:69], v[40:43]
    v_mfma_f32_16x16x16_bf16 v[44:47], v[20:21], v[70:71], v[44:47]
    s_waitcnt lgkmcnt(8)
    ds_read_b64_tr_b16 v[96:97], v7 offset:22528
    ds_read_b64_tr_b16 v[98:99], v7 offset:22560
    ds_read_b64_tr_b16 v[100:101], v7 offset:22592
    ds_read_b64_tr_b16 v[102:103], v7 offset:22624
    v_mfma_f32_16x16x16_bf16 v[32:35], v[22:23], v[72:73], v[32:35]
    v_mfma_f32_16x16x16_bf16 v[36:39], v[22:23], v[74:75], v[36:39]
    v_mfma_f32_16x16x16_bf16 v[40:43], v[22:23], v[76:77], v[40:43]
    v_mfma_f32_16x16x16_bf16 v[44:47], v[22:23], v[78:79], v[44:47]
    s_waitcnt lgkmcnt(8)
    v_mfma_f32_16x16x16_bf16 v[32:35], v[24:25], v[80:81], v[32:35]
    v_mfma_f32_16x16x16_bf16 v[36:39], v[24:25], v[82:83], v[36:39]
    v_mfma_f32_16x16x16_bf16 v[40:43], v[24:25], v[84:85], v[40:43]
    v_mfma_f32_16x16x16_bf16 v[44:47], v[24:25], v[86:87], v[44:47]
    s_waitcnt lgkmcnt(4)
    v_mfma_f32_16x16x16_bf16 v[32:35], v[26:27], v[88:89], v[32:35]
    v_mfma_f32_16x16x16_bf16 v[36:39], v[26:27], v[90:91], v[36:39]
    v_mfma_f32_16x16x16_bf16 v[40:43], v[26:27], v[92:93], v[40:43]
    v_mfma_f32_16x16x16_bf16 v[44:47], v[26:27], v[94:95], v[44:47]
    s_waitcnt lgkmcnt(0)
    v_mfma_f32_16x16x16_bf16 v[32:35], v[28:29], v[96:97], v[32:35]
    v_mfma_f32_16x16x16_bf16 v[36:39], v[28:29], v[98:99], v[36:39]
    v_mfma_f32_16x16x16_bf16 v[40:43], v[28:29], v[100:101], v[40:43]
    v_mfma_f32_16x16x16_bf16 v[44:47], v[28:29], v[102:103], v[44:47]
    global_load_dword v15, v14, s[18:19] sc1
    s_nop 4
    v_mov_b32_dpp v32, v36 quad_perm:[0,1,2,3] row_mask:0x2 bank_mask:0xf
    v_mov_b32_dpp v33, v37 quad_perm:[0,1,2,3] row_mask:0x2 bank_mask:0xf
    s_nop 0
    v_mov_b32_dpp v32, v40 quad_perm:[0,1,2,3] row_mask:0x4 bank_mask:0xf
    v_mov_b32_dpp v33, v41 quad_perm:[0,1,2,3] row_mask:0x4 bank_mask:0xf
    s_nop 0
    v_mov_b32_dpp v32, v44 quad_perm:[0,1,2,3] row_mask:0x8 bank_mask:0xf
    v_mov_b32_dpp v33, v45 quad_perm:[0,1,2,3] row_mask:0x8 bank_mask:0xf
    v_bfi_b32 v32, s26, v10, v32
    v_bfi_b32 v33, s26, v10, v33
    s_waitcnt vmcnt(0)
    v_cmp_ne_u32 vcc, s31, v15
    s_cbranch_vccnz L_qrem
    global_store_dword v8, v32, s[18:19] offset:-2048
    global_store_dword v8, v33, s[18:19] offset:2048
    s_branch L_qpub
L_qrem:
    global_store_dword v8, v32, s[18:19] offset:-2048 sc1
    global_store_dword v8, v33, s[18:19] offset:2048 sc1
L_qpub:
    s_mov_b32 s36, 524288
    s_waitcnt vmcnt(0)
L_qpoll:
    s_sleep 16
    global_load_dwordx4 v[16:19], v9, s[18:19] offset:0 sc1
    global_load_dwordx4 v[20:23], v9, s[18:19] offset:1024 sc1
    global_load_dwordx4 v[24:27], v9, s[18:19] offset:2048 sc1
    global_load_dwordx4 v[28:31], v9, s[18:19] offset:3072 sc1
    s_sub_u32 s36, s36, 1
    s_cbranch_scc1 L_qgo
    s_waitcnt vmcnt(0)
    v_xor_b32 v16, s32, v16
    v_xor_b32 v17, s32, v17
    v_xor_b32 v18, s32, v18
    v_xor_b32 v19, s32, v19
    v_xor_b32 v20, s32, v20
    v_xor_b32 v21, s32, v21
    v_xor_b32 v22, s32, v22
    v_xor_b32 v23, s32, v23
    v_xor_b32 v24, s32, v24
    v_xor_b32 v25, s32, v25
    v_xor_b32 v26, s32, v26
    v_xor_b32 v27, s32, v27
    v_xor_b32 v28, s32, v28
    v_xor_b32 v29, s32, v29
    v_xor_b32 v30, s32, v30
    v_xor_b32 v31, s32, v31
    v_or3_b32 v12, v16, v17, v18
    v_or3_b32 v12, v12, v19, v20
    v_or3_b32 v12, v12, v21, v22
    v_or3_b32 v12, v12, v23, v24
    v_or3_b32 v12, v12, v25, v26
    v_or3_b32 v12, v12, v27, v28
    v_or3_b32 v12, v12, v29, v30
    v_or_b32 v12, v12, v31
    v_and_b32 v12, s26, v12
    v_cmp_ne_u32 vcc, 0, v12
    s_cbranch_vccnz L_qpoll
L_qgo:
    v_add_f32 v16, v16, v20
    v_add_f32 v24, v24, v28
    v_add_f32 v17, v17, v21
    v_add_f32 v25, v25, v29
    v_add_f32 v18, v18, v22
    v_add_f32 v26, v26, v30
    v_add_f32 v19, v19, v23
    v_add_f32 v27, v27, v31
    v_add_f32 v16, v16, v24
    v_add_f32 v17, v17, v25
    v_add_f32 v18, v18, v26
    v_add_f32 v19, v19, v27
    v_cvt_pk_bf16_f32 v16, v16, v17
    v_cvt_pk_bf16_f32 v17, v18, v19
    v_lshlrev_b32 v5, 3, v2
    ds_write_b64 v5, v[16:17] offset:512
    v_mov_b32 v5, 0
    v_mov_b32 v7, s33
    ds_write_b32 v5, v7 offset:276
    ds_write_b32 v5, v5 offset:64
    s_setprio 0
    s_branch L_hgo
L_pad20:
    s_mov_b64 exec, -1
L_hwait:
    v_mov_b32 v5, 0
    s_mov_b32 s36, 2097152
L_hw:
    s_sleep 4
    ds_read_b32 v8, v5 offset:64
    s_sub_u32 s36, s36, 1
    s_cbranch_scc1 L_hgo
    s_waitcnt lgkmcnt(0)
    v_cmp_eq_u32 vcc, -1, v8
    s_cbranch_vccnz L_hw
L_hgo:
    v_mov_b32 v28, 0
    ds_read_b32 v6, v28 offset:276
    s_sub_u32 s25, s20, 4
    s_movk_i32 s26, 1023
    s_not_b32 s29, s26
    s_and_b32 s27, s34, 3
    s_lshl2_add_u32 s38, s23, s27
    v_and_b32 v7, 7, v2
    v_lshlrev_b32 v27, 4, v2
    s_lshl_b32 s27, s23, 8
    s_add_u32 s27, s27, 4096
    v_and_b32 v14, 31, v2
    v_lshl_add_u32 v14, v14, 2, s27
    global_load_dword v11, v14, s[18:19] sc1
    s_add_u32 s27, s27, 128
    v_min_u32 v14, 27, v2
    v_lshl_add_u32 v14, v14, 2, s27
    s_lshl2_add_u32 s27, s34, s27
    v_mov_b32 v12, s27
    s_waitcnt lgkmcnt(0)
    v_readfirstlane_b32 s33, v6
    v_mov_b32 v13, v6
    s_getreg_b32 s31, hwreg(HW_REG_XCC_ID, 0, 4)
    s_lshl_b32 s31, s31, 28
    s_xor_b32 s31, s31, s33
    s_and_b32 s32, s33, 1023
    v_mov_b32 v15, s32
    s_lshr_b32 s27, s38, 1
    s_lshl_b32 s27, s27, 13
    s_and_b32 s28, s38, 1
    s_lshl2_add_u32 s28, s28, s25
    s_lshl_b32 s28, s28, 7
    s_add_u32 s27, s27, s28
    s_add_u32 s27, s27, 524288
    v_lshrrev_b32 v6, 3, v2
    v_lshlrev_b32 v6, 10, v6
    v_lshl_add_u32 v6, v7, 4, v6
    v_add_u32 v20, s27, v6
    v_add_u32 v25, 0x20000, v20
    s_lshl_b32 s27, s25, 8
    v_lshl_add_u32 v21, v2, 2, s27
    s_lshl3_add_u32 s28, s21, s22
    s_lshl_b32 s28, s28, 10
    s_add_u32 s28, s28, 524288
    v_add_u32 v22, s28, v21
    v_add_u32 v21, 2048, v21
    s_lshl2_add_u32 s27, s22, s25
    s_lshl_b32 s27, s27, 5
    s_add_u32 s27, s27, s38
    s_lshl_b32 s27, s27, 7
    s_add_u32 s27, s27, 786432
    v_lshl_add_u32 v23, v2, 2, s27
    s_lshl_b32 s27, s38, 12
    s_lshl_b32 s28, s25, 5
    s_add_u32 s27, s27, s28
    s_add_u32 s27, s27, 786432
    v_lshrrev_b32 v6, 1, v2
    v_lshlrev_b32 v6, 7, v6
    v_and_b32 v8, 1, v2
    v_lshl_add_u32 v6, v8, 4, v6
    v_add_u32 v24, s27, v6
    s_lshr_b32 s27, s25, 1
    s_mul_i32 s27, s27, 896
    s_lshl_b32 s28, s38, 5
    s_add_u32 s27, s27, s28
    s_and_b32 s28, s25, 1
    s_lshl4_add_u32 s27, s28, s27
    v_lshl_add_u32 v26, v8, 3, s27
    v_lshl_add_u32 v26, v3, 1, v26
    s_lshl_b32 s27, s25, 6
    v_lshl_add_u32 v29, v7, 3, s27
    v_lshl_add_u32 v29, v3, 1, v29
    v_bfe_u32 v6, v2, 3, 1
    v_lshl_add_u32 v29, v6, 8, v29
    v_lshlrev_b32 v30, 4, v3
    v_lshl_add_u32 v30, v8, 8, v30
    v_and_b32 v10, 1, v3
    v_lshl_add_u32 v6, v10, 1, v6
    v_xor_b32 v6, s25, v6
    v_bfe_u32 v9, v2, 2, 2
    v_lshl_add_u32 v9, v3, 3, v9
    v_lshlrev_b32 v9, 7, v9
    v_lshl_add_u32 v9, v6, 5, v9
    v_and_b32 v6, 3, v2
    v_lshl_add_u32 v9, v6, 3, v9
    s_waitcnt vmcnt(0)
    v_cmp_ne_u32 vcc, s31, v11
    s_cmp_eq_u64 vcc, 0
    s_cselect_b32 s30, 1, 0
    s_cmp_eq_u32 s20, 5
    s_cbranch_scc1 L_bal
    s_cmp_lg_u32 s20, 4
    s_cbranch_scc1 L_nogat
    v_and_b32 v16, 12, v2
    s_mov_b32 s36, 524288
L_c1:
    s_sleep 8
    ds_read_b32 v17, v16 offset:16
    s_sub_u32 s36, s36, 1
    s_cbranch_scc1 L_c1go
    s_waitcnt lgkmcnt(0)
    v_cmp_eq_u32 vcc, -1, v17
    s_cbranch_vccnz L_c1
L_c1go:
    ds_read_b32 v17, v16 offset:288
    ds_read_b128 v[32:35], v27 offset:6144
    ds_read_b128 v[36:39], v27 offset:7168
    ds_read_b128 v[40:43], v27 offset:8192
    ds_read_b128 v[44:47], v27 offset:9216
    s_mul_i32 s27, s2, 256
    s_add_u32 s27, s27, 65536
    v_add_u32 v18, s27, v27
    s_waitcnt lgkmcnt(0)
    v_max_f32_dpp v56, v17, v17 row_ror:4 row_mask:0xf bank_mask:0xf
    v_add_f32 v32, v32, v33
    v_add_f32 v34, v34, v35
    v_max_f32_dpp v56, v56, v56 row_ror:8 row_mask:0xf bank_mask:0xf
    v_and_b32 v56, s29, v56
    v_sub_f32 v19, v17, v56
    v_exp_f32 v19, v19
    v_add_f32 v32, v32, v36
    v_add_f32 v34, v34, v37
    v_add_f32 v32, v32, v38
    v_add_f32 v34, v34, v39
    v_add_f32 v32, v32, v40
    v_add_f32 v34, v34, v41
    v_add_f32 v32, v32, v42
    v_add_f32 v34, v34, v43
    v_add_f32 v32, v32, v44
    v_add_f32 v34, v34, v45
    v_add_f32 v32, v32, v46
    v_add_f32 v34, v34, v47
    v_add_f32 v32, v32, v34
    v_mul_f32 v57, v32, v19
    s_nop 1
    v_add_f32_dpp v57, v57, v57 quad_perm:[1,0,3,2] row_mask:0xf bank_mask:0xf
    s_nop 1
    v_add_f32_dpp v57, v57, v57 quad_perm:[2,3,0,1] row_mask:0xf bank_mask:0xf
    s_nop 1
    v_add_f32_dpp v57, v57, v57 row_half_mirror row_mask:0xf bank_mask:0xf
    s_nop 1
    v_add_f32_dpp v57, v57, v57 row_mirror row_mask:0xf bank_mask:0xf
    v_mov_b32 v58, v57
    s_nop 1
    v_permlane16_swap_b32 v57, v58
    v_add_f32 v57, v57, v58
    v_mov_b32 v58, v57
    s_nop 1
    v_permlane32_swap_b32 v57, v58
    v_add_f32 v57, v57, v58
    v_or_b32 v56, v56, v15
    v_bfi_b32 v57, s26, v15, v57
    v_mov_b32 v58, s33
    v_mov_b32 v59, s33
    s_mov_b64 exec, 0xff
    s_cmp_eq_u32 s30, 0
    s_cbranch_scc1 L_mrem
    global_store_dwordx4 v18, v[56:59], s[18:19]
    s_branch L_mdone
L_mrem:
    global_store_dwordx4 v18, v[56:59], s[18:19] sc1
L_mdone:
    s_mov_b64 exec, -1
    s_and_b32 s27, s2, 31
    s_mul_i32 s27, s27, 256
    s_add_u32 s27, s27, 65536
    v_mul_u32_u24 v18, 8192, v7
    v_add_u32 v18, s27, v18
    s_mov_b32 s36, 524288
L_c2:
    s_sleep 8
    ds_read_b64 v[48:49], v28 offset:32
    s_sub_u32 s36, s36, 1
    s_cbranch_scc1 L_c2go
    s_waitcnt lgkmcnt(0)
    v_cmp_gt_i32 vcc, 22, v49
    s_cbranch_vccnz L_c2
L_c2go:
    s_mov_b32 s36, 524288
    s_branch L_xp1
L_xp:
    s_sleep 32
L_xp1:
    global_load_dwordx4 v[56:59], v18, s[18:19] sc1
    s_sub_u32 s36, s36, 1
    s_cbranch_scc1 L_xgo
    s_waitcnt vmcnt(0)
    v_xor_b32 v56, s32, v56
    v_xor_b32 v57, s32, v57
    v_xor_b32 v59, s33, v59
    v_or_b32 v31, v56, v57
    v_and_or_b32 v31, v31, s26, v59
    v_cmp_ne_u32 vcc, 0, v31
    s_cbranch_vccnz L_xp
L_xgo:
    v_max_f32_dpp v32, v56, v56 quad_perm:[1,0,3,2] row_mask:0xf bank_mask:0xf
    s_nop 1
    v_max_f32_dpp v32, v32, v32 quad_perm:[2,3,0,1] row_mask:0xf bank_mask:0xf
    s_nop 1
    v_max_f32_dpp v32, v32, v32 row_half_mirror row_mask:0xf bank_mask:0xf
    v_sub_f32 v56, v56, v32
    v_sub_f32 v17, v17, v32
    v_exp_f32 v56, v56
    v_exp_f32 v17, v17
    v_mul_f32 v33, v56, v57
    s_nop 1
    v_add_f32_dpp v33, v33, v33 quad_perm:[1,0,3,2] row_mask:0xf bank_mask:0xf
    s_nop 1
    v_add_f32_dpp v33, v33, v33 quad_perm:[2,3,0,1] row_mask:0xf bank_mask:0xf
    s_nop 1
    v_add_f32_dpp v33, v33, v33 row_half_mirror row_mask:0xf bank_mask:0xf
    v_rcp_f32 v33, v33
    s_nop 0
    v_mul_f32 v17, v17, v33
    ds_write_b32 v16, v17 offset:0
    s_branch L_nogat
L_bal:
    s_mul_i32 s27, s2, 256
    s_add_u32 s27, s27, 131072
    v_lshl_add_u32 v18, v4, 3, s27
    v_and_b32 v19, 63, v2
    v_mul_u32_u24 v19, 256, v19
    v_add_u32 v19, 131072, v19
    s_mov_b32 s24, 5
    s_mov_b32 s35, 1721
    v_mov_b32 v51, s33
    s_mov_b32 s37, 0
L_pc0:
    s_mov_b32 s36, 524288
L_p1:
    s_sleep 4
    ds_read_b64 v[48:49], v28 offset:32
    s_sub_u32 s36, s36, 1
    s_cbranch_scc1 L_p1go
    s_waitcnt lgkmcnt(0)
    v_cmp_gt_i32 vcc, s24, v49
    s_cbranch_vccnz L_p1
L_p1go:
    v_subrev_u32 v49, s24, v49
    v_mul_u32_u24 v49, 107, v49
    v_sub_u32 v50, v48, v49
    s_cmp_ge_u32 s2, 64
    s_cbranch_scc1 L_pc1
    s_mov_b64 exec, 0xffff
    global_store_dwordx2 v18, v[50:51], s[18:19] sc1
    s_mov_b64 exec, -1
L_pc1:
    s_add_u32 s27, s24, 2
    s_mov_b32 s36, 524288
L_p2:
    s_sleep 4
    ds_read_b64 v[48:49], v28 offset:32
    s_sub_u32 s36, s36, 1
    s_cbranch_scc1 L_p2go
    s_waitcnt lgkmcnt(0)
    v_cmp_gt_i32 vcc, s27, v49
    s_cbranch_vccnz L_p2
L_p2go:
    s_mov_b32 s36, 524288
    s_branch L_pp1
L_pp:
    s_sleep 32
L_pp1:
    global_load_dwordx2 v[52:53], v19, s[18:19] sc1
    s_sub_u32 s36, s36, 1
    s_cbranch_scc1 L_ppgo
    s_waitcnt vmcnt(0)
    v_cmp_ne_u32 vcc, s33, v53
    s_and_b64 exec, exec, vcc
    s_cbranch_scc1 L_pp
L_ppgo:
    s_mov_b64 exec, -1
    v_sub_u32 v52, v52, v50
    v_add_u32 v18, 16384, v18
    v_add_u32 v19, 16384, v19
    v_add_u32_dpp v52, v52, v52 quad_perm:[1,0,3,2] row_mask:0xf bank_mask:0xf
    s_nop 1
    v_add_u32_dpp v52, v52, v52 quad_perm:[2,3,0,1] row_mask:0xf bank_mask:0xf
    s_nop 1
    v_add_u32_dpp v52, v52, v52 row_half_mirror row_mask:0xf bank_mask:0xf
    s_nop 1
    v_add_u32_dpp v52, v52, v52 row_mirror row_mask:0xf bank_mask:0xf
    s_nop 1
    v_readlane_b32 s27, v52, 0
    v_readlane_b32 s28, v52, 16
    v_readlane_b32 s48, v52, 32
    v_readlane_b32 s49, v52, 48
    v_readfirstlane_b32 s31, v50
    s_add_u32 s27, s27, s28
    s_add_u32 s48, s48, s49
    s_add_u32 s27, s27, s48
    s_ashr_i32 s27, s27, 6
    s_add_u32 s27, s27, s31
    s_sub_u32 s28, s27, s37
    s_mul_i32 s28, s28, 512
    s_lshr_b32 s28, s28, 8
    s_max_u32 s28, s28, 1721
    s_cmp_eq_u32 s24, 5
    s_cselect_b32 s35, s35, s28
    s_mov_b32 s37, s27
    s_mul_i32 s28, s24, s35
    s_lshr_b32 s28, s28, 4
    s_sub_u32 s27, s27, s28
    s_add_u32 s27, s27, 10
    v_mov_b32 v52, s27
    v_mov_b32 v53, s35
    ds_write_b64 v28, v[52:53] offset:264
    s_add_u32 s24, s24, 8
    s_cmp_lt_u32 s24, 29
    s_cbranch_scc1 L_pc0
    s_cmp_lg_u32 s2, 255
    s_cbranch_scc1 L_nogat
    global_store_dword v28, v51, s[18:19] sc1
L_nogat:
    s_mov_b32 s36, 524288
    s_branch L_f1
L_f0:
    s_sleep 8
L_f1:
    ds_read_b128 v[44:47], v28 offset:0
    s_sub_u32 s36, s36, 1
    s_cbranch_scc1 L_fgo
    s_waitcnt lgkmcnt(0)
    v_cmp_eq_u32 vcc, -1, v44
    s_cbranch_vccnz L_f0
L_fgo:
    ds_read_b64_tr_b16 v[64:65], v9 offset:24576
    ds_read_b64_tr_b16 v[66:67], v9 offset:25088
    ds_read_b64_tr_b16 v[68:69], v9 offset:28672
    ds_read_b64_tr_b16 v[70:71], v9 offset:29184
    ds_read_b64_tr_b16 v[72:73], v9 offset:32768
    ds_read_b64_tr_b16 v[74:75], v9 offset:33280
    ds_read_b64_tr_b16 v[76:77], v9 offset:36864
    ds_read_b64_tr_b16 v[78:79], v9 offset:37376
    s_mov_b32 s36, 2097152
    s_cmp_lg_u32 s30, 0
L_pad16:
    s_cbranch_execz L_pad17
    s_waitcnt vmcnt(0) lgkmcnt(0)
    s_barrier
    ds_read2st64_b32 v[32:33], v21 offset0:0 offset1:4
    ds_read2st64_b32 v[34:35], v21 offset0:8 offset1:12
    s_waitcnt lgkmcnt(0)
    v_pk_mul_f32 v[32:33], v[32:33], v[44:45]
    v_pk_fma_f32 v[32:33], v[34:35], v[46:47], v[32:33]
    v_add_f32 v32, v32, v33
    v_bfi_b32 v32, s26, v15, v32
    s_cbranch_scc0 L_orem
    global_store_dword v22, v32, s[18:19]
L_odone:
    s_cmp_ge_u32 s34, 28
    s_cbranch_scc1 L_final
L_h1poll:
    global_load_dwordx4 v[36:39], v20, s[18:19] sc1
    global_load_dwordx4 v[40:43], v25, s[18:19] sc1
    s_sub_u32 s36, s36, 1
    s_cbranch_scc1 L_h1go
L_pad17:
    s_cbranch_execz L_pad18
    s_waitcnt vmcnt(0)
    v_xor_b32 v36, s32, v36
    v_xor_b32 v37, s32, v37
    v_xor_b32 v38, s32, v38
    v_xor_b32 v39, s32, v39
    v_xor_b32 v40, s32, v40
    v_xor_b32 v41, s32, v41
    v_xor_b32 v42, s32, v42
    v_xor_b32 v43, s32, v43
    v_or3_b32 v31, v36, v37, v38
    v_or3_b32 v32, v39, v40, v41
    v_or3_b32 v31, v31, v42, v43
    v_or_b32 v31, v31, v32
    v_and_b32 v31, s26, v31
    v_cmp_ne_u32 vcc, 0, v31
    s_and_b64 exec, exec, vcc
    s_cbranch_scc1 L_h1poll
L_h1go:
    s_mov_b64 exec, -1
    v_permlane32_swap_b32 v36, v38
    v_permlane32_swap_b32 v37, v39
    v_permlane32_swap_b32 v40, v42
    v_permlane32_swap_b32 v41, v43
    v_add_f32 v36, v36, v38
    v_add_f32 v37, v37, v39
    v_add_f32 v40, v40, v42
    v_add_f32 v41, v41, v43
    v_permlane16_swap_b32 v36, v37
    v_add_f32 v36, v36, v37
    v_permlane16_swap_b32 v40, v41
    v_add_f32 v40, v40, v41
    v_add_f32_dpp v37, v36, v36 row_ror:8 row_mask:0xf bank_mask:0x3
    s_nop 1
    v_add_f32_dpp v37, v40, v40 row_ror:8 row_mask:0xf bank_mask:0xc
    v_cvt_pk_bf16_f32 v37, v37, v37
    ds_write_b16 v29, v37 offset:1024
    s_waitcnt lgkmcnt(0)
    s_barrier
    ds_read_b128 v[40:43], v30 offset:1024
    ds_read_b128 v[44:47], v30 offset:1088
    ds_read_b128 v[48:51], v30 offset:1152
    ds_read_b128 v[52:55], v30 offset:1216
L_pad18:
    s_cbranch_execz L_pad19
    s_waitcnt lgkmcnt(3)
    v_mfma_f32_16x16x32_bf16 v[56:59], v[40:43], v[64:67], 0
    s_waitcnt lgkmcnt(2)
    v_mfma_f32_16x16x32_bf16 v[56:59], v[44:47], v[68:71], v[56:59]
    s_waitcnt lgkmcnt(1)
    v_mfma_f32_16x16x32_bf16 v[56:59], v[48:51], v[72:75], v[56:59]
    s_waitcnt lgkmcnt(0)
    v_mfma_f32_16x16x32_bf16 v[56:59], v[52:55], v[76:79], v[56:59]
    s_mov_b32 exec_hi, 0
    s_nop 6
    v_mov_b32_dpp v56, v57 quad_perm:[0,1,2,3] row_mask:0x2 bank_mask:0xf
    v_bfi_b32 v56, s26, v15, v56
    global_store_dword v23, v56, s[18:19] sc1
    global_store_dword v12, v13, s[18:19]
    s_endpgm
L_final:
    s_cmp_eq_u32 s23, 7
    s_cbranch_scc1 L_end
    s_cmp_eq_u32 s30, 0
    s_cbranch_scc1 L_h2poll
L_g2:
    global_load_dword v32, v14, s[18:19] sc1
    s_sub_u32 s36, s36, 1
    s_cbranch_scc1 L_h2go
    s_waitcnt vmcnt(0)
    v_cmp_ne_u32 vcc, s33, v32
    s_cbranch_vccnz L_g2
L_h2poll:
    global_load_dwordx4 v[32:35], v24, s[18:19] sc1
L_pad19:
    s_cbranch_execz L_pad20
    s_sub_u32 s36, s36, 1
    s_cbranch_scc1 L_h2go
    s_waitcnt vmcnt(0)
    v_xor_b32 v32, s32, v32
    v_xor_b32 v33, s32, v33
    v_xor_b32 v34, s32, v34
    v_xor_b32 v35, s32, v35
    v_or3_b32 v31, v32, v33, v34
    v_or_b32 v31, v31, v35
    v_and_b32 v31, s26, v31
    v_cmp_ne_u32 vcc, 0, v31
    s_and_b64 exec, exec, vcc
    s_cbranch_scc1 L_h2poll
L_h2go:
    s_mov_b64 exec, -1
    v_permlane32_swap_b32 v32, v34
    v_permlane32_swap_b32 v33, v35
    v_add_f32 v32, v32, v34
    v_add_f32 v33, v33, v35
    s_nop 1
    v_permlane16_swap_b32 v32, v33
    v_add_f32 v32, v32, v33
    s_nop 1
    v_add_f32_dpp v32, v32, v32 row_ror:8 row_mask:0xf bank_mask:0xf
    s_nop 1
    v_add_f32_dpp v32, v32, v32 row_ror:4 row_mask:0xf bank_mask:0xf
    s_nop 1
    v_add_f32_dpp v32, v32, v32 row_ror:2 row_mask:0xf bank_mask:0xf
    s_mov_b32 exec_lo, 0x00030003
    s_mov_b32 exec_hi, 0x00030003
    v_cvt_pk_bf16_f32 v32, v32, v32
    global_store_short v26, v32, s[14:15]
L_end:
    s_endpgm
L_orem:
    global_store_dword v22, v32, s[18:19] sc1
L_last:
    s_branch L_odone
.section .rodata,"a"
.p2align 6
.amdhsa_kernel standalone__mha_block_cached__decode_kernel
  .amdhsa_next_free_vgpr 182
  .amdhsa_next_free_sgpr 56
  .amdhsa_accum_offset 184
  .amdhsa_group_segment_fixed_size 0
  .amdhsa_kernarg_size 64
  .amdhsa_user_sgpr_count 2
  .amdhsa_user_sgpr_kernarg_segment_ptr 1
  .amdhsa_system_sgpr_workgroup_id_x 1
.end_amdhsa_kernel
```
